```python
import torch

def _softmax(x, axis=-1):
    return torch.softmax(x, dim=axis)
def _gelu(x):
    return torch.nn.functional.gelu(x, approximate="tanh")
def _silu(x):
    return torch.nn.functional.silu(x)
def _sigmoid(x):
    return torch.sigmoid(x)
def _layernorm(x, axis=-1, eps=1e-5):
    m = x.mean(dim=axis, keepdim=True)
    v = x.var(dim=axis, keepdim=True, unbiased=False)
    return (x - m) / torch.sqrt(v + eps)
def _scatter_add(tgt, idx, src, axis=0):
    return tgt.clone().index_add_(axis, idx, src)
def _segment_sum(src, seg, n):
    out = torch.zeros((n,) + src.shape[1:], dtype=src.dtype)
    return out.index_add_(0, seg, src)
def _pad(x, pw):
    flat = tuple(v for pair in reversed(pw) for v in pair)
    return torch.nn.functional.pad(x, flat)

kernel_name = 'concat_heads__sliding_block_cached__sliding_block_cached__decode'

def setup_inputs():

    _w = (lambda a: (lambda t: t.to(torch.bfloat16) if t.is_floating_point() else t)(torch.as_tensor(a)))
    def _A_setup():
        B, Sq, D = 1, 1, 1024
        Hq, Hkv, Sk, Dh = 32, 4, 65536, 128
        assert Hq % Hkv == 0, (Hq, Hkv)
        return {
            "x": _w((lambda *s: torch.randn(*s, dtype=torch.bfloat16) * 1.6)(B, Sq, D)),
            "k_cache": _w((lambda *s: torch.randn(*s, dtype=torch.bfloat16) * 1.6)(B, Hkv, Sk, Dh)),
            "v_cache": _w((lambda *s: torch.randn(*s, dtype=torch.bfloat16) * 0.05)(B, Hkv, Sk, Dh)),
            "wq": _w((lambda *s: torch.randn(*s, dtype=torch.bfloat16) * 1.6)(D, Hq * Dh) * (D ** -0.5)),
            "wo": _w((lambda *s: torch.randn(*s, dtype=torch.bfloat16) * 0.05)(Hq * Dh, D) * ((Hq * Dh) ** -0.5)),
        }
    _A_in = _A_setup()

    def _B_setup():
        B, Sq, D = 1, 1, 1024
        Hq, Hkv, Sk, Dh = 32, 4, 65536, 128
        assert Hq % Hkv == 0, (Hq, Hkv)
        return {
            "x": _w((lambda *s: torch.randn(*s, dtype=torch.bfloat16) * 1.6)(B, Sq, D)),
            "k_cache": _w((lambda *s: torch.randn(*s, dtype=torch.bfloat16) * 1.6)(B, Hkv, Sk, Dh)),
            "v_cache": _w((lambda *s: torch.randn(*s, dtype=torch.bfloat16) * 0.05)(B, Hkv, Sk, Dh)),
            "wq": _w((lambda *s: torch.randn(*s, dtype=torch.bfloat16) * 1.6)(D, Hq * Dh) * (D ** -0.5)),
            "wo": _w((lambda *s: torch.randn(*s, dtype=torch.bfloat16) * 0.05)(Hq * Dh, D) * ((Hq * Dh) ** -0.5)),
        }
    _B_in = _B_setup()

    return {
        "A_x": _A_in["x"],
        "A_k_cache": _A_in["k_cache"],
        "A_v_cache": _A_in["v_cache"],
        "A_wq": _A_in["wq"],
        "A_wo": _A_in["wo"],
        "B_x": _B_in["x"],
        "B_k_cache": _B_in["k_cache"],
        "B_v_cache": _B_in["v_cache"],
        "B_wq": _B_in["wq"],
        "B_wo": _B_in["wo"],
    }

def reference(A_x, A_k_cache, A_v_cache, A_wq, A_wo, B_x, B_k_cache, B_v_cache, B_wq, B_wo):
    def _A_ref(x, k_cache, v_cache, wq, wo):
        B, Sq, D = x.shape
        Hq, Dh = 32, 128
        Hkv, Sk = k_cache.shape[1], k_cache.shape[2]
        W = min(4096, max(256, Sk // 4))
        rep = Hq // Hkv
        q = (lambda x, *d: x.permute(*d))((x @ wq).reshape(B, Sq, Hq, Dh), 0, 2, 1, 3)
        k = (lambda x, n, axis: torch.repeat_interleave(x, n, dim=axis))(k_cache[:, :, Sk - W:, :], rep, axis=1)
        v = (lambda x, n, axis: torch.repeat_interleave(x, n, dim=axis))(v_cache[:, :, Sk - W:, :], rep, axis=1)
        scores = torch.einsum("bhqd,bhkd->bhqk", q, k) * (Dh ** -0.5)
        p = _softmax(scores, axis=-1)
        o = torch.einsum("bhqk,bhkd->bhqd", p, v)
        return (lambda x, *d: x.permute(*d))(o, 0, 2, 1, 3).reshape(B, Sq, Hq * Dh) @ wo

    def _B_ref(x, k_cache, v_cache, wq, wo):
        B, Sq, D = x.shape
        Hq, Dh = 32, 128
        Hkv, Sk = k_cache.shape[1], k_cache.shape[2]
        W = min(4096, max(256, Sk // 4))
        rep = Hq // Hkv
        q = (lambda x, *d: x.permute(*d))((x @ wq).reshape(B, Sq, Hq, Dh), 0, 2, 1, 3)
        k = (lambda x, n, axis: torch.repeat_interleave(x, n, dim=axis))(k_cache[:, :, Sk - W:, :], rep, axis=1)
        v = (lambda x, n, axis: torch.repeat_interleave(x, n, dim=axis))(v_cache[:, :, Sk - W:, :], rep, axis=1)
        scores = torch.einsum("bhqd,bhkd->bhqk", q, k) * (Dh ** -0.5)
        p = _softmax(scores, axis=-1)
        o = torch.einsum("bhqk,bhkd->bhqd", p, v)
        return (lambda x, *d: x.permute(*d))(o, 0, 2, 1, 3).reshape(B, Sq, Hq * Dh) @ wo

    a = _A_ref(A_x, A_k_cache, A_v_cache, A_wq, A_wo)
    b = _B_ref(B_x, B_k_cache, B_v_cache, B_wq, B_wo)
    return torch.concatenate([a, b], axis=-1)
```

```asm
; @launch grid=(256,1,1) block=(512,1,1) lds=88128
.amdgcn_target "amdgcn-amd-amdhsa--gfx950"
.text
.globl concat_heads__sliding_block_cached__sliding_block_cached__decode_kernel
.p2align 8
.type concat_heads__sliding_block_cached__sliding_block_cached__decode_kernel,@function
concat_heads__sliding_block_cached__sliding_block_cached__decode_kernel:
    s_cmp_ge_u32 s2, 256
    s_cbranch_scc1 L_end
    s_bfe_u32 s4, s2, 0x10002
    s_mul_i32 s100, s4, 40
    s_load_dwordx2 s[40:41], s[0:1], s100 offset:24
    s_load_dwordx2 s[28:29], s[0:1], s100
    v_lshrrev_b32 v1, 6, v0
    v_and_b32 v0, 63, v0
    s_and_b32 s5, s2, 3
    v_readfirstlane_b32 s3, v1
    s_lshr_b32 s8, s2, 5
    s_bfe_u32 s9, s2, 0x20003
    s_lshl3_add_u32 s34, s5, s8
    s_cmp_lg_u32 s3, 0
    s_cbranch_scc1 L_nopf
    s_getpc_b64 s[14:15]
L_pc:
    v_lshlrev_b32 v1, 7, v0
    v_min_u32 v1, L_codeend-L_pc-4, v1
    global_load_dword v160, v1, s[14:15]
L_nopf:
    v_lshrrev_b32 v1, 4, v0
    v_and_b32 v11, 15, v0
    s_lshl3_add_u32 s32, s9, s3
    v_lshlrev_b32 v10, 4, v11
    s_lshl_b32 s11, s32, 6
    s_lshl_b32 s32, s32, 18
    s_lshl_b32 s7, s34, 8
    s_add_u32 s32, s32, s7
    v_lshl_add_u32 v2, v1, 16, v10
    s_lshl_b32 s42, 1, 23
    s_lshl_b32 s43, 1, 17
    v_lshlrev_b32 v3, 4, v1
    s_movk_i32 s30, 0x800
    s_mov_b32 s31, s43
    s_waitcnt lgkmcnt(0)
    buffer_load_dwordx4 v[32:35], v2, s[40:43], s32 offen nt
    s_add_u32 s32, s32, 8192
    buffer_load_dwordx4 v[16:19], v3, s[28:31], s11 offen
    s_lshr_b32 s6, s2, 3
    s_and_b32 s10, s2, 7
    s_barrier
    buffer_load_dwordx4 v[36:39], v2, s[40:43], s32 offen nt
    s_add_u32 s32, s32, 8192
    v_and_b32 v25, 7, v0
    v_lshlrev_b32 v166, 2, v25
    v_add_u32 v166, 72960, v166
    v_mov_b32 v182, 0xff800000
    v_mov_b32 v187, 72992
    v_mov_b32 v192, 0
    v_mov_b32 v193, 1
    ds_write_b32 v166, v182
    ds_write_b64 v187, v[192:193]
    ds_write_b32 v187, v192 offset:8
    s_waitcnt lgkmcnt(0)
    s_barrier
    buffer_load_dwordx4 v[40:43], v2, s[40:43], s32 offen nt
    s_add_u32 s32, s32, 8192
    s_load_dwordx2 s[24:25], s[0:1], 96
    s_load_dwordx4 s[44:47], s[0:1], s100 offset:8
    s_load_dwordx2 s[20:21], s[0:1], 80
    s_load_dwordx2 s[52:53], s[0:1], s100 offset:32
    v_and_b32 v20, 1, v0
    v_mov_b32 v21, 0xffff
    v_lshlrev_b32 v20, 4, v20
    v_lshlrev_b32 v21, v20, v21
    v_bfe_u32 v20, v0, 1, 2
    v_cmp_eq_u32 vcc, 0, v20
    v_cmp_eq_u32 s[14:15], 1, v20
    v_mov_b32 v24, 1073741824
    v_cndmask_b32 v12, 0, v21, vcc
    v_cmp_eq_u32 vcc, 2, v20
    v_cndmask_b32 v13, 0, v21, s[14:15]
    v_cmp_eq_u32 s[14:15], 3, v20
    v_cndmask_b32 v14, 0, v21, vcc
    s_lshl_b32 s12, s4, 7
    v_cndmask_b32 v15, 0, v21, s[14:15]
    s_mov_b32 s26, 4194304
    s_mov_b32 s27, 0x20000
    s_getreg_b32 s63, hwreg(HW_REG_XCC_ID, 0, 3)
    s_waitcnt lgkmcnt(0)
    s_load_dword s17, s[24:25], s12
    s_waitcnt vmcnt(2)
    s_mov_b32 s7, 0x1000100
    v_perm_b32 v25, v16, v16, s7
    v_and_b32 v20, v25, v12
    v_and_b32 v21, v25, v13
    v_and_b32 v22, v25, v14
    v_and_b32 v23, v25, v15
    s_waitcnt vmcnt(3)
    buffer_load_dwordx4 v[44:47], v2, s[40:43], s32 offen nt
    s_add_u32 s32, s32, 8192
    v_mfma_f32_16x16x32_bf16 v[28:31], v[20:23], v[32:35], 0
    s_mov_b32 s48, s46
    s_mov_b32 s49, s47
    s_mov_b32 s46, 0x4000000
    s_mov_b32 s47, 0x20000
    s_mov_b32 s50, 0x4000000
    s_mov_b32 s51, 0x20000
    s_lshl_b32 s33, s5, 24
    s_add_u32 s33, s33, 15728640
    s_lshl_b32 s7, s6, 15
    s_add_u32 s33, s33, s7
    s_lshl_b32 s7, s3, 12
    s_add_u32 s33, s33, s7
    s_add_u32 s37, s7, 0
    s_add_u32 s38, s7, 32768
    v_lshlrev_b32 v195, 8, v1
    v_xor_b32 v196, v1, v11
    v_lshl_add_u32 v4, v196, 4, v195
    v_xor_b32 v5, 64, v4
    v_xor_b32 v6, 128, v4
    v_xor_b32 v7, 192, v4
    v_lshlrev_b32 v26, 1, v1
    v_xor_b32 v26, v26, v11
    v_lshl_add_u32 v8, v26, 4, v195
    v_xor_b32 v9, 128, v8
    v_lshlrev_b32 v26, 8, v11
    v_lshl_add_u32 v26, v196, 4, v26
    v_add_u32 v161, s37, v26
    v_xor_b32 v162, 64, v161
    v_xor_b32 v163, 128, v161
    v_xor_b32 v164, 192, v161
    s_mov_b32 s7, 0x3020302
    v_perm_b32 v25, v16, v16, s7
    v_and_b32 v20, v25, v12
    v_and_b32 v21, v25, v13
    v_and_b32 v22, v25, v14
    v_and_b32 v23, v25, v15
    s_waitcnt vmcnt(2)
    buffer_load_dwordx4 v[48:51], v2, s[40:43], s32 offen nt
    s_add_u32 s32, s32, 8192
    v_mfma_f32_16x16x32_bf16 v[28:31], v[20:23], v[36:39], v[28:31]
    s_cmp_eq_u32 s3, 0
    s_cselect_b64 s[14:15], -1, 0
    s_waitcnt lgkmcnt(0)
    s_add_u32 s17, s17, 1
    s_and_b32 s16, s17, 1023
    s_lshl_b32 s101, s63, 7
    s_xor_b32 s101, s101, s16
    v_mov_b32 v183, s16
    v_mov_b32 v204, s101
    v_mov_b32 v207, s101
    v_mov_b32 v208, s101
    v_mov_b32 v209, s101
    s_mov_b32 s18, 0xfffffc00
    s_mov_b32 s19, 0
    s_lshl_b32 s36, s10, 14
    s_add_u32 s36, s36, 65536
    s_lshl_b32 s7, s3, 11
    s_add_u32 s39, s36, s7
    s_lshl_b32 s7, s6, 9
    s_add_u32 s36, s36, s7
    s_mul_i32 s7, s3, 640
    s_add_u32 s101, s7, 65536
    v_mul_u32_u24 v26, 384, v1
    v_lshl_add_u32 v26, v11, 4, v26
    v_add_u32 v170, s101, v26
    v_and_b32 v26, 1, v0
    v_mul_u32_u24 v26, 384, v26
    v_bfe_u32 v27, v0, 1, 4
    v_lshl_add_u32 v171, v27, 4, v26
    v_lshrrev_b32 v27, 5, v0
    v_mul_u32_u24 v26, 2560, v27
    v_add_u32 v171, v171, v26
    v_add_u32 v171, 65536, v171
    v_and_b32 v26, 31, v0
    v_lshlrev_b32 v195, 4, v26
    v_cmp_gt_u32 vcc, 32, v0
    v_mov_b32 v172, v24
    s_lshr_b32 s7, s3, 1
    s_lshl_b32 s7, s7, 7
    s_and_b32 s101, s3, 1
    s_add_u32 s7, s7, s101
    s_lshl_b32 s7, s7, 3
    s_add_u32 s101, s7, 73280
    v_cndmask_b32 v186, v24, v195, vcc
    s_mov_b32 s7, 0x1000100
    v_perm_b32 v25, v17, v17, s7
    v_and_b32 v20, v25, v12
    v_and_b32 v21, v25, v13
    v_and_b32 v22, v25, v14
    v_and_b32 v23, v25, v15
    s_waitcnt vmcnt(2)
    buffer_load_dwordx4 v[52:55], v2, s[40:43], s32 offen nt
    s_add_u32 s32, s32, 8192
    v_mfma_f32_16x16x32_bf16 v[28:31], v[20:23], v[40:43], v[28:31]
    s_mul_i32 s7, s3, 288
    v_lshlrev_b32 v173, 3, v26
    v_lshl_add_u32 v173, v27, 2, v173
    s_add_u32 s7, s7, 70656
    v_add_u32 v173, s7, v173
    v_lshlrev_b32 v167, 4, v0
    v_add_u32 v168, 73280, v167
    v_add_u32 v167, s101, v167
    v_and_b32 v26, 7, v0
    v_mul_u32_u24 v27, 288, v26
    v_lshl_add_u32 v27, v1, 4, v27
    v_add_u32 v165, 70656, v27
    v_lshlrev_b32 v184, 5, v26
    v_add_u32 v184, 73024, v184
    s_lshl_b32 s7, s3, 2
    v_add_u32 v185, s7, v184
    s_mov_b32 s7, 0x3020302
    v_perm_b32 v25, v17, v17, s7
    v_and_b32 v20, v25, v12
    v_and_b32 v21, v25, v13
    v_and_b32 v22, v25, v14
    v_and_b32 v23, v25, v15
    s_waitcnt vmcnt(2)
    buffer_load_dwordx4 v[56:59], v2, s[40:43], s32 offen nt
    s_add_u32 s32, s32, 8192
    v_mfma_f32_16x16x32_bf16 v[28:31], v[20:23], v[44:47], v[28:31]
    s_mov_b32 s54, 0x800000
    s_mov_b32 s55, 0x20000
    s_mov_b32 s22, 4096
    s_mov_b32 s23, 0x20000
    s_lshl_b32 s35, s34, 18
    s_lshl_b32 s7, s3, 15
    s_add_u32 s35, s35, s7
    s_lshl_b32 s7, s9, 9
    s_add_u32 s35, s35, s7
    v_and_b32 v26, 1, v1
    v_lshrrev_b32 v27, 1, v1
    v_lshl_add_u32 v26, v26, 2, v27
    v_lshl_add_u32 v10, v26, 11, v10
    v_and_b32 v26, 3, v0
    v_mov_b32 v202, 0xffff
    v_mov_b32 v203, 0xffff0000
    v_cmp_eq_u32 vcc, 3, v26
    v_or_b32 v27, 12, v26
    v_mul_u32_u24 v27, 0x1111, v27
    v_mov_b32 v201, 0xcccc
    v_cndmask_b32 v202, v202, v203, vcc
    v_cndmask_b32 v201, v27, v201, vcc
    v_and_b32 v26, 4, v0
    v_cmp_eq_u32 vcc, 0, v26
    s_lshl_b32 s7, s3, 11
    s_add_u32 s57, s7, 1048576
    v_cndmask_b32 v203, v202, 0, vcc
    v_cndmask_b32 v202, 0, v202, vcc
    s_lshl_b32 s7, s10, 17
    s_add_u32 s57, s57, s7
    s_lshl_b32 s7, s6, 6
    s_add_u32 s56, s57, s7
    s_lshl_b32 s7, s8, 14
    s_add_u32 s57, s57, s7
    s_lshl_b32 s59, s10, 12
    s_add_u32 s59, s59, 196608
    s_lshl_b32 s7, s6, 4
    s_add_u32 s58, s59, s7
    s_lshl_b32 s7, s8, 9
    s_add_u32 s59, s59, s7
    s_mov_b32 s7, 0x1000100
    v_perm_b32 v25, v18, v18, s7
    v_and_b32 v20, v25, v12
    v_and_b32 v21, v25, v13
    v_and_b32 v22, v25, v14
    v_and_b32 v23, v25, v15
    s_waitcnt vmcnt(2)
    buffer_load_dwordx4 v[60:63], v2, s[40:43], s32 offen nt
    s_add_u32 s32, s32, 8192
    v_mfma_f32_16x16x32_bf16 v[28:31], v[20:23], v[48:51], v[28:31]
    v_bfe_u32 v195, v0, 2, 2
    v_lshl_add_u32 v195, v1, 2, v195
    v_and_b32 v26, 7, v195
    v_bfe_u32 v27, v0, 1, 1
    s_lshl_b32 s101, s3, 1
    v_or_b32 v27, s101, v27
    v_lshlrev_b32 v26, 1, v26
    v_xor_b32 v27, v27, v26
    v_lshlrev_b32 v195, 8, v195
    v_lshl_add_u32 v195, v27, 4, v195
    v_and_b32 v26, 1, v0
    v_lshl_add_u32 v195, v26, 3, v195
    v_add_u32 v169, 32768, v195
    v_lshlrev_b32 v27, 4, v1
    v_lshl_add_u32 v174, v11, 14, v27
    v_cmp_gt_u32 vcc, 8, v11
    v_lshlrev_b32 v175, 9, v0
    v_lshrrev_b32 v176, 2, v0
    v_cndmask_b32 v174, v24, v174, vcc
    v_cmp_gt_u32 vcc, 8, v0
    s_and_b64 vcc, vcc, s[14:15]
    v_lshlrev_b32 v176, 4, v176
    v_cndmask_b32 v175, v24, v175, vcc
    s_mov_b32 s7, 0x3020302
    v_perm_b32 v25, v18, v18, s7
    v_and_b32 v20, v25, v12
    v_and_b32 v21, v25, v13
    v_and_b32 v22, v25, v14
    v_and_b32 v23, v25, v15
    s_waitcnt vmcnt(2)
    s_mov_b32 m0, s37
    s_nop 0
    buffer_load_dwordx4 v4, s[44:47], s33 offen offset:0 nt lds
    v_mfma_f32_16x16x32_bf16 v[28:31], v[20:23], v[52:55], v[28:31]
    s_lshl2_add_u32 s62, s4, s9
    s_lshl_b32 s60, s62, 15
    s_add_u32 s60, s60, 262144
    s_lshl_b32 s7, s34, 5
    s_add_u32 s61, s60, s7
    s_lshl_b32 s7, s34, 10
    s_add_u32 s60, s60, s7
    s_lshl_b32 s7, s3, 7
    s_add_u32 s60, s60, s7
    s_lshl_b32 s62, s62, 9
    s_lshl_b32 s101, s34, 4
    s_add_u32 s62, s62, s101
    s_mov_b32 s96, 0x3db504f3
    s_mov_b32 s97, 0x3db504f3
    s_mov_b32 s98, 0x3fb8aa3b
    s_mov_b32 s99, 0x3fb8aa3b
    v_lshrrev_b32 v27, 3, v0
    v_and_b32 v26, 7, v0
    v_mul_u32_u24 v178, 1216, v26
    v_and_b32 v195, 1, v27
    v_mul_u32_u24 v195, 288, v195
    v_lshrrev_b32 v196, 1, v27
    v_lshl_add_u32 v195, v196, 4, v195
    v_add_u32 v178, v178, v195
    s_lshr_b32 s7, s3, 2
    s_mul_i32 s7, s7, 576
    s_and_b32 s101, s3, 3
    s_lshl_b32 s101, s101, 6
    s_add_u32 s7, s7, s101
    s_add_u32 s7, s7, 77376
    v_add_u32 v178, s7, v178
    v_lshlrev_b32 v179, 4, v27
    v_cmp_eq_u32 vcc, 0, v26
    v_lshrrev_b32 v27, 5, v0
    v_mul_u32_u24 v177, 576, v27
    v_cndmask_b32 v179, v24, v179, vcc
    s_mov_b32 s7, 0x1000100
    v_perm_b32 v25, v19, v19, s7
    v_and_b32 v20, v25, v12
    v_and_b32 v21, v25, v13
    v_and_b32 v22, v25, v14
    v_and_b32 v23, v25, v15
    s_waitcnt vmcnt(2)
    buffer_load_dwordx4 v5, s[44:47], s33 offen offset:1024 nt lds
    v_mfma_f32_16x16x32_bf16 v[28:31], v[20:23], v[56:59], v[28:31]
    v_lshl_add_u32 v177, v11, 4, v177
    v_and_b32 v27, 1, v1
    v_mul_u32_u24 v27, 288, v27
    v_add_u32 v177, v27, v177
    s_mul_i32 s7, s3, 1216
    s_add_u32 s7, s7, 77376
    v_add_u32 v177, s7, v177
    v_lshrrev_b32 v180, 1, v0
    v_and_b32 v26, 1, v0
    v_lshlrev_b32 v180, 10, v180
    v_lshl_add_u32 v180, v26, 4, v180
    v_lshlrev_b32 v181, 3, v26
    v_lshl_add_u32 v181, v1, 1, v181
    v_and_b32 v27, 14, v0
    v_cmp_eq_u32 vcc, 0, v27
    v_cmp_eq_u32 s[100:101], 0, v0
    v_lshlrev_b32 v11, 4, v0
    v_cndmask_b32 v181, v24, v181, vcc
    v_cndmask_b32 v205, v24, 0, s[100:101]
    s_mov_b32 s7, 0x3020302
    v_perm_b32 v25, v19, v19, s7
    v_and_b32 v20, v25, v12
    v_and_b32 v21, v25, v13
    v_and_b32 v22, v25, v14
    v_and_b32 v23, v25, v15
    s_waitcnt vmcnt(2)
    buffer_load_dwordx4 v6, s[44:47], s33 offen offset:2048 nt lds
    v_mfma_f32_16x16x32_bf16 v[28:31], v[20:23], v[60:63], v[28:31]
    s_mov_b32 exec_hi, 0
    s_nop 6
    ds_write_b128 v170, v[28:31]
    s_mov_b64 exec, 1
    ds_add_rtn_u32 v25, v187, v193
    s_mov_b64 exec, -1
    s_waitcnt lgkmcnt(0)
    v_readfirstlane_b32 s7, v25
    s_cmp_lg_u32 s7, 7
    s_cbranch_scc1 L_nored
    ds_read_b128 v[96:99], v171
    ds_read_b128 v[100:103], v171 offset:640
    ds_read_b128 v[104:107], v171 offset:1280
    ds_read_b128 v[108:111], v171 offset:1920
    v_mov_b32 v172, v186
    s_waitcnt lgkmcnt(2)
    v_pk_add_f32 v[96:97], v[96:97], v[100:101]
    v_pk_add_f32 v[98:99], v[98:99], v[102:103]
    s_waitcnt lgkmcnt(0)
    v_pk_add_f32 v[104:105], v[104:105], v[108:109]
    v_pk_add_f32 v[106:107], v[106:107], v[110:111]
    v_pk_add_f32 v[96:97], v[96:97], v[104:105]
    v_pk_add_f32 v[98:99], v[98:99], v[106:107]
    s_nop 1
    v_permlane32_swap_b32 v96, v98
    v_permlane32_swap_b32 v97, v99
    v_pk_add_f32 v[96:97], v[96:97], v[98:99]
    v_add_u32 v96, 512, v96
    v_add_u32 v97, 512, v97
    v_and_or_b32 v100, v96, s18, v183
    v_and_or_b32 v101, v97, s18, v183
    v_and_or_b32 v96, v96, s18, v204
    v_and_or_b32 v97, v97, s18, v204
    v_permlane32_swap_b32 v100, v102
    v_permlane32_swap_b32 v101, v103
    v_permlane32_swap_b32 v96, v98
    v_permlane32_swap_b32 v97, v99
    v_add_u32 v25, 87616, v11
    s_mov_b32 exec_hi, 0
    ds_write_b128 v25, v[100:103]
    s_mov_b32 exec_hi, -1
    ds_write_b32 v187, v193 offset:8
L_nored:
    buffer_store_dwordx4 v[96:99], v172, s[24:27], s36 offen
    s_waitcnt vmcnt(3)
    buffer_load_dwordx4 v7, s[44:47], s33 offen offset:3072 nt lds
    s_waitcnt vmcnt(3)
    s_mov_b32 m0, s38
    s_nop 0
    buffer_load_dwordx4 v8, s[48:51], s33 offen offset:0 nt lds
    buffer_load_dword v194, v205, s[24:27], s60 offen
    s_waitcnt vmcnt(4)
    buffer_load_dwordx4 v9, s[48:51], s33 offen offset:1024 nt lds
    s_waitcnt vmcnt(3)
    buffer_load_dwordx4 v8, s[48:51], s33 offen offset:2048 nt lds
    ds_read_b128 v[96:99], v161
    ds_read_b128 v[100:103], v162
    ds_read_b128 v[104:107], v163
    ds_read_b128 v[108:111], v164
    s_waitcnt vmcnt(3)
    buffer_load_dwordx4 v9, s[48:51], s33 offen offset:3072 nt lds
    buffer_load_dwordx4 v[128:131], v11, s[24:27], s39 offen sc1
    buffer_load_dwordx4 v[132:135], v11, s[24:27], s39 offen offset:1024 sc1
    s_waitcnt vmcnt(4)
    buffer_load_dwordx4 v[64:67], v10, s[52:55], s35 offen offset:0 nt
    s_waitcnt vmcnt(4)
    buffer_load_dwordx4 v[72:75], v10, s[52:55], s35 offen offset:256 nt
    s_add_u32 s35, s35, 4096
    s_waitcnt vmcnt(4)
    buffer_load_dwordx4 v[68:71], v10, s[52:55], s35 offen offset:0 nt
    s_waitcnt vmcnt(3)
L_x1_chk:
    v_xor_b32 v136, v204, v128
    v_xor_b32 v137, v207, v129
    v_xor_b32 v138, v208, v130
    v_xor_b32 v139, v209, v131
    v_xor_b32 v140, v204, v132
    v_xor_b32 v141, v207, v133
    v_xor_b32 v142, v208, v134
    v_xor_b32 v143, v209, v135
    v_or3_b32 v24, v136, v137, v138
    v_or3_b32 v24, v24, v139, v140
    v_or3_b32 v24, v24, v141, v142
    v_or_b32 v24, v24, v143
    v_and_b32 v24, 1023, v24
    v_cmp_ne_u32 vcc, 0, v24
    s_cbranch_vccnz L_x1_retry
L_x1_ok:
    s_cmp_lg_u32 s19, 0
    s_cbranch_scc1 L_fast1
    buffer_load_dwordx4 v[76:79], v10, s[52:55], s35 offen offset:256 nt
    s_add_u32 s35, s35, 12288
L_fjoin1:
    v_pk_add_f32 v[136:137], v[136:137], v[140:141]
    v_pk_add_f32 v[138:139], v[138:139], v[142:143]
    s_nop 1
    v_permlane32_swap_b32 v136, v138
    v_permlane32_swap_b32 v137, v139
    v_pk_add_f32 v[136:137], v[136:137], v[138:139]
    v_cvt_pk_bf16_f32 v136, v136, v137
    ds_write_b32 v173, v136
    s_waitcnt lgkmcnt(0)
    s_barrier
    ds_read_b128 v[112:115], v165 offset:0
    ds_read_b128 v[116:119], v165 offset:64
    ds_read_b128 v[120:123], v165 offset:128
    ds_read_b128 v[124:127], v165 offset:192
    ds_read_b32 v26, v187 offset:4
    s_waitcnt lgkmcnt(4)
    v_mfma_f32_16x16x32_bf16 v[28:31], v[96:99], v[112:115], 0
    s_waitcnt lgkmcnt(3)
    v_mfma_f32_16x16x32_bf16 v[28:31], v[100:103], v[116:119], v[28:31]
    s_waitcnt lgkmcnt(2)
    v_mfma_f32_16x16x32_bf16 v[28:31], v[104:107], v[120:123], v[28:31]
    s_waitcnt lgkmcnt(1)
    v_mfma_f32_16x16x32_bf16 v[28:31], v[108:111], v[124:127], v[28:31]
    s_waitcnt lgkmcnt(0)
    v_readfirstlane_b32 s13, v26
    ds_read_b64_tr_b16 v[32:33], v169 offset:0
    ds_read_b64_tr_b16 v[34:35], v169 offset:4096
    ds_read_b64_tr_b16 v[36:37], v169 offset:8192
    ds_read_b64_tr_b16 v[38:39], v169 offset:12288
    ds_read_b64_tr_b16 v[40:41], v169 offset:16384
    ds_read_b64_tr_b16 v[42:43], v169 offset:20480
    ds_read_b64_tr_b16 v[44:45], v169 offset:24576
    ds_read_b64_tr_b16 v[46:47], v169 offset:28672
    v_cvt_pk_bf16_f32 v20, v28, v29
    v_cvt_pk_bf16_f32 v21, v30, v31
    v_lshlrev_b32 v28, 16, v20
    v_and_b32 v29, 0xffff0000, v20
    v_lshlrev_b32 v30, 16, v21
    v_and_b32 v31, 0xffff0000, v21
    v_pk_mul_f32 v[28:29], v[28:29], s[96:97]
    v_pk_mul_f32 v[30:31], v[30:31], s[96:97]
    v_cvt_pk_bf16_f32 v20, v28, v29
    v_cvt_pk_bf16_f32 v21, v30, v31
    v_lshlrev_b32 v28, 16, v20
    v_and_b32 v29, 0xffff0000, v20
    v_lshlrev_b32 v30, 16, v21
    v_and_b32 v31, 0xffff0000, v21
    v_max3_f32 v22, v28, v29, v30
    v_max_f32 v22, v22, v31
    s_mov_b32 exec_lo, 0x00ff00ff
    s_mov_b32 exec_hi, 0x00ff00ff
    ds_max_f32 v166, v22
    s_mov_b64 exec, -1
    s_waitcnt lgkmcnt(0)
    s_barrier
    ds_read_b32 v188, v166
    s_cmp_lg_u32 s19, 0
    s_cbranch_scc1 L_fast2
    buffer_load_dwordx4 v[80:83], v10, s[52:55], s35 offen offset:0 nt
    buffer_load_dwordx4 v[88:91], v10, s[52:55], s35 offen offset:256 nt
    s_add_u32 s35, s35, 4096
L_fjoin2:
    s_waitcnt lgkmcnt(0)
    v_sub_f32 v28, v28, v188
    v_sub_f32 v29, v29, v188
    v_sub_f32 v30, v30, v188
    v_sub_f32 v31, v31, v188
    v_pk_mul_f32 v[28:29], v[28:29], s[98:99]
    v_pk_mul_f32 v[30:31], v[30:31], s[98:99]
    v_exp_f32 v28, v28
    v_exp_f32 v29, v29
    v_exp_f32 v30, v30
    v_exp_f32 v31, v31
    v_cvt_pk_bf16_f32 v20, v28, v29
    v_cvt_pk_bf16_f32 v21, v30, v31
    ds_write_b64 v167, v[20:21]
    v_pk_add_f32 v[28:29], v[28:29], v[30:31]
    v_add_f32 v28, v28, v29
    v_mov_b32 v29, v28
    s_nop 1
    v_permlane16_swap_b32 v28, v29
    v_add_f32 v28, v28, v29
    v_mov_b32 v29, v28
    s_nop 1
    v_permlane32_swap_b32 v28, v29
    v_add_f32 v28, v28, v29
    s_mov_b64 exec, 0xff
    ds_write_b32 v185, v28
    s_mov_b64 exec, -1
    s_waitcnt lgkmcnt(0)
    s_barrier
    ds_read_b128 v[48:51], v168 offset:0
    ds_read_b128 v[52:55], v168 offset:1024
    ds_read_b128 v[56:59], v168 offset:2048
    ds_read_b128 v[60:63], v168 offset:3072
    ds_read_b128 v[104:107], v184
    ds_read_b128 v[108:111], v184 offset:16
    s_waitcnt lgkmcnt(5)
    v_mfma_f32_16x16x32_bf16 v[28:31], v[32:35], v[48:51], 0
    s_waitcnt lgkmcnt(4)
    v_mfma_f32_16x16x32_bf16 v[28:31], v[36:39], v[52:55], v[28:31]
    s_waitcnt lgkmcnt(3)
    v_mfma_f32_16x16x32_bf16 v[28:31], v[40:43], v[56:59], v[28:31]
    s_waitcnt lgkmcnt(2)
    v_mfma_f32_16x16x32_bf16 v[28:31], v[44:47], v[60:63], v[28:31]
    s_waitcnt lgkmcnt(0)
    v_pk_add_f32 v[104:105], v[104:105], v[106:107]
    v_pk_add_f32 v[108:109], v[108:109], v[110:111]
    v_and_or_b32 v100, v188, s18, v183
    v_pk_add_f32 v[104:105], v[104:105], v[108:109]
    v_mov_b32 v102, v183
    v_add_f32 v104, v104, v105
    v_mov_b32 v103, v183
    v_and_or_b32 v101, v104, s18, v183
    s_cmp_lg_u32 s13, 0
    v_and_or_b32 v28, v28, s18, v183
    v_and_or_b32 v29, v29, s18, v183
    v_and_or_b32 v30, v30, s18, v183
    v_and_or_b32 v31, v31, s18, v183
    s_cbranch_scc0 L_p2_thru
    buffer_store_dwordx4 v[28:31], v174, s[24:27], s56 offen
    buffer_store_dwordx4 v[100:103], v175, s[24:27], s58 offen
L_p2_done:
    s_cmp_lg_u32 s19, 0
    s_cbranch_scc1 L_fast3
    buffer_load_dwordx4 v[84:87], v10, s[52:55], s35 offen offset:0 nt
    buffer_load_dwordx4 v[92:95], v10, s[52:55], s35 offen offset:256 nt
L_fjoin3:
    s_waitcnt vmcnt(0)
    buffer_load_dwordx4 v[144:147], v176, s[24:27], s59 offen sc1
    buffer_load_dwordx4 v[148:151], v176, s[24:27], s59 offen offset:256 sc1
    buffer_load_dwordx4 v[128:131], v11, s[24:27], s57 offen sc1
    buffer_load_dwordx4 v[132:135], v11, s[24:27], s57 offen offset:1024 sc1
    v_mov_b32 v28, 0
    v_mov_b32 v20, 0
    v_mov_b32 v29, 0
    v_mov_b32 v21, 0
    v_mov_b32 v30, 0
    v_mov_b32 v22, 0
    v_mov_b32 v31, 0
    v_mov_b32 v23, 0
    s_waitcnt vmcnt(0)
L_x2_chk:
    v_xor_b32 v152, v183, v144
    v_xor_b32 v153, v183, v148
    v_max_f32 v24, v152, v153
    v_xor_b32 v136, v183, v128
    v_xor_b32 v137, v183, v129
    v_max_f32_dpp v24, v24, v24 row_ror:8 row_mask:0xf bank_mask:0xf
    v_xor_b32 v138, v183, v130
    v_xor_b32 v139, v183, v131
    v_max_f32_dpp v24, v24, v24 row_ror:4 row_mask:0xf bank_mask:0xf
    v_mov_b32 v25, v24
    v_xor_b32 v140, v183, v132
    v_xor_b32 v141, v183, v133
    v_permlane16_swap_b32 v24, v25
    v_max_f32 v24, v24, v25
    v_mov_b32 v25, v24
    v_xor_b32 v142, v183, v134
    v_xor_b32 v143, v183, v135
    v_permlane32_swap_b32 v24, v25
    v_max_f32 v24, v24, v25
    v_sub_f32 v156, v152, v24
    v_sub_f32 v157, v153, v24
    v_pk_mul_f32 v[156:157], v[156:157], s[98:99]
    v_or3_b32 v26, v152, v153, v136
    v_exp_f32 v156, v156
    v_or3_b32 v26, v26, v137, v138
    v_exp_f32 v157, v157
    v_or3_b32 v26, v26, v139, v140
    v_xor_b32 v154, v183, v145
    v_xor_b32 v155, v183, v149
    v_or3_b32 v26, v26, v141, v142
    v_or3_b32 v26, v26, v143, v154
    v_bitop3_b32 v26, v26, v146, v183 bitop3:0xf6
    v_bitop3_b32 v26, v26, v147, v183 bitop3:0xf6
    v_bitop3_b32 v26, v26, v150, v183 bitop3:0xf6
    v_bitop3_b32 v26, v26, v151, v183 bitop3:0xf6
    v_or_b32 v26, v26, v155
    v_and_b32 v26, 1023, v26
    v_cmp_ne_u32 vcc, 0, v26
    s_cbranch_vccnz L_x2_retry
L_x2_ok:
    v_mul_f32 v196, v136, v156
    v_mul_f32 v198, v138, v156
    v_pk_mul_f32 v[158:159], v[154:155], v[156:157]
    v_mul_f32 v197, v137, v156
    v_mul_f32 v199, v139, v156
    v_add_f32 v158, v158, v159
    v_fmac_f32 v196, v140, v157
    v_fmac_f32 v198, v142, v157
    v_add_f32_dpp v158, v158, v158 row_ror:8 row_mask:0xf bank_mask:0xf
    v_fmac_f32 v197, v141, v157
    v_fmac_f32 v199, v143, v157
    v_add_f32_dpp v158, v158, v158 row_ror:4 row_mask:0xf bank_mask:0xf
    v_permlane32_swap_b32 v196, v198
    v_mov_b32 v159, v158
    v_permlane32_swap_b32 v197, v199
    v_pk_add_f32 v[196:197], v[196:197], v[198:199]
    v_permlane16_swap_b32 v158, v159
    v_add_f32 v158, v158, v159
    v_permlane16_swap_b32 v196, v197
    v_mov_b32 v159, v158
    v_add_f32 v196, v196, v197
    s_nop 0
    v_permlane32_swap_b32 v158, v159
    v_add_f32_dpp v196, v196, v196 row_ror:8 row_mask:0xf bank_mask:0xf
    v_add_f32 v158, v158, v159
    v_rcp_f32 v158, v158
    v_add_f32_dpp v196, v196, v196 row_ror:4 row_mask:0xf bank_mask:0xf
    v_mul_f32 v196, v196, v158
    v_cvt_pk_bf16_f32 v136, v196, v196
    s_nop 1
    v_and_b32_dpp v112, v136, v202 quad_perm:[0,0,0,0] row_mask:0xf bank_mask:0xf
    v_and_b32_dpp v113, v136, v203 quad_perm:[0,0,0,0] row_mask:0xf bank_mask:0xf
    v_and_b32_dpp v114, v136, v202 quad_perm:[1,1,1,1] row_mask:0xf bank_mask:0xf
    v_and_b32_dpp v115, v136, v203 quad_perm:[1,1,1,1] row_mask:0xf bank_mask:0xf
    s_nop 1
    v_smfmac_f32_16x16x64_bf16 v[28:31], v[112:115], v[64:71], v201
    v_smfmac_f32_16x16x64_bf16 v[20:23], v[112:115], v[72:79], v201
    v_and_b32_dpp v116, v136, v202 quad_perm:[2,2,2,2] row_mask:0xf bank_mask:0xf
    v_and_b32_dpp v117, v136, v203 quad_perm:[2,2,2,2] row_mask:0xf bank_mask:0xf
    v_and_b32_dpp v118, v136, v202 quad_perm:[3,3,3,3] row_mask:0xf bank_mask:0xf
    v_and_b32_dpp v119, v136, v203 quad_perm:[3,3,3,3] row_mask:0xf bank_mask:0xf
    s_nop 1
    v_smfmac_f32_16x16x64_bf16 v[28:31], v[116:119], v[80:87], v201
    v_smfmac_f32_16x16x64_bf16 v[20:23], v[116:119], v[88:95], v201
    s_nop 7
    v_permlane32_swap_b32 v28, v20
    v_permlane32_swap_b32 v29, v21
    v_permlane32_swap_b32 v30, v22
    v_permlane32_swap_b32 v31, v23
    ds_write_b128 v177, v[28:31]
    s_waitcnt lgkmcnt(0)
    s_barrier
    ds_read_b128 v[96:99], v178
    s_waitcnt lgkmcnt(0)
    v_add_f32_dpp v96, v96, v96 quad_perm:[1,0,3,2] row_mask:0xf bank_mask:0xf
    v_add_f32_dpp v97, v97, v97 quad_perm:[1,0,3,2] row_mask:0xf bank_mask:0xf
    v_add_f32_dpp v98, v98, v98 quad_perm:[1,0,3,2] row_mask:0xf bank_mask:0xf
    v_add_f32_dpp v99, v99, v99 quad_perm:[1,0,3,2] row_mask:0xf bank_mask:0xf
    v_add_f32_dpp v96, v96, v96 quad_perm:[2,3,0,1] row_mask:0xf bank_mask:0xf
    v_add_f32_dpp v97, v97, v97 quad_perm:[2,3,0,1] row_mask:0xf bank_mask:0xf
    v_add_f32_dpp v98, v98, v98 quad_perm:[2,3,0,1] row_mask:0xf bank_mask:0xf
    v_add_f32_dpp v99, v99, v99 quad_perm:[2,3,0,1] row_mask:0xf bank_mask:0xf
    v_add_f32_dpp v96, v96, v96 row_half_mirror row_mask:0xf bank_mask:0xf
    v_add_f32_dpp v97, v97, v97 row_half_mirror row_mask:0xf bank_mask:0xf
    v_add_f32_dpp v98, v98, v98 row_half_mirror row_mask:0xf bank_mask:0xf
    v_add_f32_dpp v99, v99, v99 row_half_mirror row_mask:0xf bank_mask:0xf
    v_and_or_b32 v96, v96, s18, v183
    v_and_or_b32 v97, v97, s18, v183
    v_and_or_b32 v98, v98, s18, v183
    v_and_or_b32 v99, v99, s18, v183
    buffer_store_dwordx4 v[96:99], v179, s[24:27], s60 offen sc1
    s_cmp_lg_u32 s3, 0
    s_cbranch_scc1 L_fin
    s_waitcnt vmcnt(0)
    buffer_load_dwordx4 v[128:131], v180, s[24:27], s61 offen sc1
    s_waitcnt vmcnt(0)
L_x3_chk:
    v_xor_b32 v136, v183, v128
    v_xor_b32 v137, v183, v129
    v_xor_b32 v138, v183, v130
    v_xor_b32 v139, v183, v131
    v_or3_b32 v24, v136, v137, v138
    v_or_b32 v24, v24, v139
    v_and_b32 v24, 1023, v24
    v_cmp_ne_u32 vcc, 0, v24
    s_cbranch_vccnz L_x3_retry
L_x3_ok:
    v_permlane32_swap_b32 v136, v138
    v_permlane32_swap_b32 v137, v139
    v_pk_add_f32 v[136:137], v[136:137], v[138:139]
    s_nop 1
    v_permlane16_swap_b32 v136, v137
    v_add_f32 v136, v136, v137
    s_nop 1
    v_add_f32_dpp v136, v136, v136 row_ror:8 row_mask:0xf bank_mask:0xf
    s_nop 1
    v_add_f32_dpp v136, v136, v136 row_ror:4 row_mask:0xf bank_mask:0xf
    s_nop 1
    v_add_f32_dpp v136, v136, v136 quad_perm:[2,3,0,1] row_mask:0xf bank_mask:0xf
    v_cvt_pk_bf16_f32 v136, v136, v136
    buffer_store_short v136, v181, s[20:23], s62 offen
    s_or_b32 s7, s5, s6
    s_cmp_lg_u32 s7, 0
    s_cbranch_scc1 L_fin
    v_mov_b32 v1, s17
    buffer_store_dword v1, v205, s[24:27], s12 offen sc1
L_fin:
L_end:
    s_endpgm
L_x1_retry:
    s_add_u32 s19, s19, 1
    s_cmp_ge_u32 s19, 32768
    s_cbranch_scc1 L_x1_ok
    s_cmp_lt_u32 s19, 12
    s_cbranch_scc1 L_x1_same
    s_cmp_gt_u32 s19, 12
    s_cbranch_scc1 L_x1_alt
    s_mov_b32 s92, s39
    v_mov_b32 v206, v204
    v_mov_b32 v192, 0
    ds_write_b32 v187, v192 offset:4
    s_mov_b32 s93, 0
L_x1_copy:
    ds_read_b32 v25, v187 offset:8
    s_add_u32 s93, s93, 1
    s_waitcnt lgkmcnt(0)
    v_readfirstlane_b32 s7, v25
    s_cmp_ge_u32 s93, 32768
    s_cbranch_scc1 L_x1_have
    s_cmp_eq_u32 s7, 0
    s_cbranch_scc1 L_x1_copy
L_x1_have:
    v_and_b32 v25, 511, v11
    v_add_u32 v25, 87616, v25
    ds_read_b128 v[144:147], v25
    s_bfe_u32 s7, s17, 0xa000a
    v_mov_b32 v210, s7
    s_bfe_u32 s7, s17, 0xa0014
    v_mov_b32 v211, s7
    s_lshr_b32 s7, s17, 30
    v_mov_b32 v212, s7
    s_add_u32 s7, s36, 458752
    s_waitcnt lgkmcnt(0)
    v_and_or_b32 v145, v145, s18, v210
    v_and_or_b32 v146, v146, s18, v211
    v_and_or_b32 v147, v147, s18, v212
    buffer_store_dwordx4 v[144:147], v186, s[24:27], s7 offen sc1
L_x1_alt:
    s_and_b32 s7, s19, 1
    s_cselect_b32 s7, 0, 458752
    s_add_u32 s39, s92, s7
    s_cmp_eq_u32 s7, 0
    s_cselect_b64 vcc, -1, 0
    s_nop 0
    v_cndmask_b32 v204, v183, v206, vcc
    v_cndmask_b32 v207, v210, v206, vcc
    v_cndmask_b32 v208, v211, v206, vcc
    v_cndmask_b32 v209, v212, v206, vcc
L_x1_same:
    buffer_load_dwordx4 v[128:131], v11, s[24:27], s39 offen sc1
    buffer_load_dwordx4 v[132:135], v11, s[24:27], s39 offen offset:1024 sc1
    s_waitcnt vmcnt(0)
    s_branch L_x1_chk
L_fast1:
    s_branch L_fjoin1
L_fast2:
    buffer_load_dwordx4 v[76:79], v10, s[52:55], s35 offen offset:256 nt
    s_add_u32 s35, s35, 12288
    s_branch L_fjoin2
L_p2_thru:
    buffer_store_dwordx4 v[28:31], v174, s[24:27], s56 offen sc1
    buffer_store_dwordx4 v[100:103], v175, s[24:27], s58 offen sc1
    s_branch L_p2_done
L_fast3:
    buffer_load_dwordx4 v[80:83], v10, s[52:55], s35 offen offset:0 nt
    buffer_load_dwordx4 v[88:91], v10, s[52:55], s35 offen offset:256 nt
    s_add_u32 s35, s35, 4096
    buffer_load_dwordx4 v[84:87], v10, s[52:55], s35 offen offset:0 nt
    buffer_load_dwordx4 v[92:95], v10, s[52:55], s35 offen offset:256 nt
    s_branch L_fjoin3
L_x2_retry:
    s_add_u32 s19, s19, 1
    s_cmp_ge_u32 s19, 32768
    s_cbranch_scc1 L_x2_ok
    buffer_load_dwordx4 v[144:147], v176, s[24:27], s59 offen sc1
    buffer_load_dwordx4 v[148:151], v176, s[24:27], s59 offen offset:256 sc1
    buffer_load_dwordx4 v[128:131], v11, s[24:27], s57 offen sc1
    buffer_load_dwordx4 v[132:135], v11, s[24:27], s57 offen offset:1024 sc1
    s_waitcnt vmcnt(0)
    s_branch L_x2_chk
L_x3_retry:
    s_add_u32 s19, s19, 1
    s_cmp_ge_u32 s19, 32768
    s_cbranch_scc1 L_x3_ok
    s_mov_b64 exec, vcc
    buffer_load_dwordx4 v[128:131], v180, s[24:27], s61 offen sc1
    s_mov_b64 exec, -1
    s_waitcnt vmcnt(0)
    s_branch L_x3_chk
L_codeend:
    s_endpgm
.section .rodata,"a"
.p2align 6
.amdhsa_kernel concat_heads__sliding_block_cached__sliding_block_cached__decode_kernel
  .amdhsa_next_free_vgpr 216
  .amdhsa_next_free_sgpr 102
  .amdhsa_accum_offset 216
  .amdhsa_group_segment_fixed_size 0
  .amdhsa_kernarg_size 104
  .amdhsa_user_sgpr_count 2
  .amdhsa_user_sgpr_kernarg_segment_ptr 1
  .amdhsa_system_sgpr_workgroup_id_x 1
  .amdhsa_float_denorm_mode_32 3
.end_amdhsa_kernel
```
